```python
import torch

def _softmax(x, axis=-1):
    return torch.softmax(x, dim=axis)
def _gelu(x):
    return torch.nn.functional.gelu(x, approximate="tanh")
def _silu(x):
    return torch.nn.functional.silu(x)
def _sigmoid(x):
    return torch.sigmoid(x)
def _layernorm(x, axis=-1, eps=1e-5):
    m = x.mean(dim=axis, keepdim=True)
    v = x.var(dim=axis, keepdim=True, unbiased=False)
    return (x - m) / torch.sqrt(v + eps)
def _scatter_add(tgt, idx, src, axis=0):
    return tgt.clone().index_add_(axis, idx, src)
def _segment_sum(src, seg, n):
    out = torch.zeros((n,) + src.shape[1:], dtype=src.dtype)
    return out.index_add_(0, seg, src)
def _pad(x, pw):
    flat = tuple(v for pair in reversed(pw) for v in pair)
    return torch.nn.functional.pad(x, flat)

kernel_name = 'standalone__deepnorm__sampling'

def setup_inputs():

    _w = (lambda a: (lambda t: t.to(torch.bfloat16) if t.is_floating_point() else t)(torch.as_tensor(a)))
    B, S, D = 1024, 16, 512
    return {
        "x": _w((lambda *s: torch.randn(*s, dtype=torch.bfloat16) * 0.05)(B, S, D)),
        "f": _w((lambda *s: torch.randn(*s, dtype=torch.bfloat16) * 0.05)(B, S, D)),
        "g": _w((lambda *s: torch.randn(*s, dtype=torch.bfloat16) * 0.05)(D) + 1.0),
        "b": _w((lambda *s: torch.randn(*s, dtype=torch.bfloat16) * 0.4)(D)),
        "alpha": _w(float(2.0)),
    }

def reference(x, f, g, b, alpha):
    return _layernorm(alpha * x + f, axis=-1) * g + b
```

```asm
; @launch grid=(256,1,1) block=(1024,1,1) lds=64
.amdgcn_target "amdgcn-amd-amdhsa--gfx950"
.text
.globl standalone__deepnorm__sampling_kernel
.p2align 13
.p2align 8
.type standalone__deepnorm__sampling_kernel,@function
standalone__deepnorm__sampling_kernel:
    s_load_dwordx8 s[4:11], s[0:1], 0
    s_load_dwordx4 s[12:15], s[0:1], 32
    s_cmpk_ge_u32 s2, 256
    s_cbranch_scc1 L_end
    v_mov_b32 v7, 0
    ds_write_b32 v7, v7
    s_lshl_b32 s3, s2, 14
    s_bitset1_b32 s3, 12
    v_lshrrev_b32 v3, 8, v0
    v_and_b32 v1, 255, v0
    v_lshl_add_u32 v1, v1, 4, s3
    v_lshl_add_u32 v1, v3, 22, v1
    v_bfe_u32 v3, v0, 6, 1
    v_lshl_add_u32 v1, v3, 13, v1
    v_xor_b32 v4, 0x2000, v1
    v_and_b32 v2, 63, v0
    v_lshlrev_b32 v2, 4, v2
    s_waitcnt lgkmcnt(0)
    global_load_dwordx4 v[8:11], v1, s[4:5] offset:-4096 nt
    global_load_dwordx4 v[16:19], v4, s[4:5] offset:-4096 nt
    s_barrier
    global_load_dwordx4 v[40:43], v2, s[8:9]
    global_load_dwordx4 v[44:47], v2, s[10:11]
    s_load_dword s16, s[12:13], 0
    global_load_dwordx4 v[12:15], v1, s[6:7] offset:-4096 nt
    global_load_dwordx4 v[20:23], v4, s[6:7] offset:-4096 nt
    global_load_dwordx4 v[24:27], v1, s[4:5] offset:0 nt
    global_load_dwordx4 v[32:35], v4, s[4:5] offset:0 nt
    global_load_dwordx4 v[28:31], v1, s[6:7] offset:0 nt
    global_load_dwordx4 v[36:39], v4, s[6:7] offset:0 nt
    s_mov_b32 s20, 0xffff0000
    s_mov_b32 s22, 0x3b000000
    v_mov_b32 v3, 0x3727c5ac
    v_mov_b32 v80, 1
    s_waitcnt lgkmcnt(0)
    s_lshl_b32 s16, s16, 16
    s_waitcnt vmcnt(6)
    v_lshlrev_b32 v48, 16, v40
    v_and_b32 v49, s20, v40
    v_lshlrev_b32 v56, 16, v44
    v_and_b32 v57, s20, v44
    v_lshlrev_b32 v50, 16, v41
    v_and_b32 v51, s20, v41
    v_lshlrev_b32 v58, 16, v45
    v_and_b32 v59, s20, v45
    v_lshlrev_b32 v52, 16, v42
    v_and_b32 v53, s20, v42
    v_lshlrev_b32 v60, 16, v46
    v_and_b32 v61, s20, v46
    v_lshlrev_b32 v54, 16, v43
    v_and_b32 v55, s20, v43
    v_lshlrev_b32 v62, 16, v47
    v_and_b32 v63, s20, v47
    s_waitcnt vmcnt(5)
    v_lshlrev_b32 v64, 16, v8
    v_and_b32 v65, s20, v8
    v_lshlrev_b32 v66, 16, v9
    v_and_b32 v67, s20, v9
    v_lshlrev_b32 v8, 16, v12
    v_and_b32 v9, s20, v12
    v_lshlrev_b32 v68, 16, v10
    v_and_b32 v69, s20, v10
    v_lshlrev_b32 v70, 16, v11
    v_and_b32 v71, s20, v11
    v_lshlrev_b32 v10, 16, v13
    v_and_b32 v11, s20, v13
    v_pk_fma_f32 v[8:9], v[64:65], s[16:17], v[8:9] op_sel_hi:[1,0,1]
    v_lshlrev_b32 v12, 16, v14
    v_and_b32 v13, s20, v14
    v_pk_fma_f32 v[10:11], v[66:67], s[16:17], v[10:11] op_sel_hi:[1,0,1]
    v_lshlrev_b32 v14, 16, v15
    v_and_b32 v15, s20, v15
    v_pk_fma_f32 v[12:13], v[68:69], s[16:17], v[12:13] op_sel_hi:[1,0,1]
    v_pk_add_f32 v[64:65], v[8:9], v[10:11]
    v_pk_fma_f32 v[14:15], v[70:71], s[16:17], v[14:15] op_sel_hi:[1,0,1]
    v_pk_add_f32 v[64:65], v[64:65], v[12:13]
    v_pk_add_f32 v[64:65], v[64:65], v[14:15]
    v_add_f32 v2, v64, v65
    s_waitcnt vmcnt(4)
    v_lshlrev_b32 v64, 16, v16
    v_and_b32 v65, s20, v16
    v_lshlrev_b32 v66, 16, v17
    v_and_b32 v67, s20, v17
    v_lshlrev_b32 v16, 16, v20
    v_and_b32 v17, s20, v20
    v_lshlrev_b32 v68, 16, v18
    v_and_b32 v69, s20, v18
    v_lshlrev_b32 v70, 16, v19
    v_and_b32 v71, s20, v19
    v_lshlrev_b32 v18, 16, v21
    v_and_b32 v19, s20, v21
    v_pk_fma_f32 v[16:17], v[64:65], s[16:17], v[16:17] op_sel_hi:[1,0,1]
    v_lshlrev_b32 v20, 16, v22
    v_and_b32 v21, s20, v22
    v_pk_fma_f32 v[18:19], v[66:67], s[16:17], v[18:19] op_sel_hi:[1,0,1]
    v_lshlrev_b32 v22, 16, v23
    v_and_b32 v23, s20, v23
    v_pk_fma_f32 v[20:21], v[68:69], s[16:17], v[20:21] op_sel_hi:[1,0,1]
    v_pk_add_f32 v[64:65], v[16:17], v[18:19]
    v_pk_fma_f32 v[22:23], v[70:71], s[16:17], v[22:23] op_sel_hi:[1,0,1]
    v_pk_add_f32 v[64:65], v[64:65], v[20:21]
    v_pk_add_f32 v[64:65], v[64:65], v[22:23]
    v_add_f32 v0, v64, v65
    s_waitcnt vmcnt(1)
    v_lshlrev_b32 v64, 16, v24
    v_and_b32 v65, s20, v24
    v_lshlrev_b32 v66, 16, v25
    v_and_b32 v67, s20, v25
    v_lshlrev_b32 v24, 16, v28
    v_and_b32 v25, s20, v28
    v_lshlrev_b32 v68, 16, v26
    v_and_b32 v69, s20, v26
    v_lshlrev_b32 v70, 16, v27
    v_and_b32 v71, s20, v27
    v_lshlrev_b32 v26, 16, v29
    v_and_b32 v27, s20, v29
    v_pk_fma_f32 v[24:25], v[64:65], s[16:17], v[24:25] op_sel_hi:[1,0,1]
    v_lshlrev_b32 v28, 16, v30
    v_and_b32 v29, s20, v30
    v_pk_fma_f32 v[26:27], v[66:67], s[16:17], v[26:27] op_sel_hi:[1,0,1]
    v_lshlrev_b32 v30, 16, v31
    v_and_b32 v31, s20, v31
    v_pk_fma_f32 v[28:29], v[68:69], s[16:17], v[28:29] op_sel_hi:[1,0,1]
    v_pk_add_f32 v[64:65], v[24:25], v[26:27]
    v_pk_fma_f32 v[30:31], v[70:71], s[16:17], v[30:31] op_sel_hi:[1,0,1]
    v_pk_add_f32 v[64:65], v[64:65], v[28:29]
    v_pk_add_f32 v[64:65], v[64:65], v[30:31]
    v_add_f32 v5, v64, v65
    s_waitcnt vmcnt(0)
    s_mov_b64 exec, 1
    ds_add_u32 v7, v80
    s_mov_b64 exec, -1
    v_lshlrev_b32 v64, 16, v32
    v_and_b32 v65, s20, v32
    v_lshlrev_b32 v66, 16, v33
    v_and_b32 v67, s20, v33
    v_lshlrev_b32 v32, 16, v36
    v_and_b32 v33, s20, v36
    v_lshlrev_b32 v68, 16, v34
    v_and_b32 v69, s20, v34
    v_lshlrev_b32 v70, 16, v35
    v_and_b32 v71, s20, v35
    v_lshlrev_b32 v34, 16, v37
    v_and_b32 v35, s20, v37
    v_pk_fma_f32 v[32:33], v[64:65], s[16:17], v[32:33] op_sel_hi:[1,0,1]
    v_lshlrev_b32 v36, 16, v38
    v_and_b32 v37, s20, v38
    v_pk_fma_f32 v[34:35], v[66:67], s[16:17], v[34:35] op_sel_hi:[1,0,1]
    v_lshlrev_b32 v38, 16, v39
    v_and_b32 v39, s20, v39
    v_pk_fma_f32 v[36:37], v[68:69], s[16:17], v[36:37] op_sel_hi:[1,0,1]
    v_pk_add_f32 v[64:65], v[32:33], v[34:35]
    v_pk_fma_f32 v[38:39], v[70:71], s[16:17], v[38:39] op_sel_hi:[1,0,1]
    v_pk_add_f32 v[64:65], v[64:65], v[36:37]
    v_pk_add_f32 v[64:65], v[64:65], v[38:39]
    v_add_f32 v6, v64, v65
    s_nop 0
    v_permlane32_swap_b32 v2, v0
    v_permlane32_swap_b32 v5, v6
    v_add_f32 v2, v2, v0
    v_add_f32 v5, v5, v6
    s_nop 1
    v_permlane16_swap_b32 v2, v5
    v_add_f32 v2, v2, v5
    s_nop 1
    v_add_f32_dpp v2, v2, v2 quad_perm:[1,0,3,2] row_mask:0xf bank_mask:0xf
    s_nop 1
    v_add_f32_dpp v2, v2, v2 quad_perm:[2,3,0,1] row_mask:0xf bank_mask:0xf
    s_nop 1
    v_add_f32_dpp v2, v2, v2 row_half_mirror row_mask:0xf bank_mask:0xf
    s_nop 1
    v_add_f32_dpp v2, v2, v2 row_mirror row_mask:0xf bank_mask:0xf
    v_mul_f32 v2, s22, v2
    s_nop 0
    v_readlane_b32 s24, v2, 0
    v_readlane_b32 s26, v2, 32
    v_readlane_b32 s28, v2, 16
    v_readlane_b32 s30, v2, 48
    v_pk_add_f32 v[8:9], v[8:9], s[24:25] op_sel_hi:[1,0] neg_lo:[0,1] neg_hi:[0,1]
    v_pk_add_f32 v[10:11], v[10:11], s[24:25] op_sel_hi:[1,0] neg_lo:[0,1] neg_hi:[0,1]
    v_pk_add_f32 v[12:13], v[12:13], s[24:25] op_sel_hi:[1,0] neg_lo:[0,1] neg_hi:[0,1]
    v_pk_add_f32 v[14:15], v[14:15], s[24:25] op_sel_hi:[1,0] neg_lo:[0,1] neg_hi:[0,1]
    v_pk_mul_f32 v[64:65], v[8:9], v[8:9]
    v_pk_mul_f32 v[66:67], v[10:11], v[10:11]
    v_pk_fma_f32 v[64:65], v[12:13], v[12:13], v[64:65]
    v_pk_fma_f32 v[66:67], v[14:15], v[14:15], v[66:67]
    v_pk_add_f32 v[64:65], v[64:65], v[66:67]
    v_add_f32 v2, v64, v65
    v_pk_add_f32 v[16:17], v[16:17], s[26:27] op_sel_hi:[1,0] neg_lo:[0,1] neg_hi:[0,1]
    v_pk_add_f32 v[18:19], v[18:19], s[26:27] op_sel_hi:[1,0] neg_lo:[0,1] neg_hi:[0,1]
    v_pk_add_f32 v[20:21], v[20:21], s[26:27] op_sel_hi:[1,0] neg_lo:[0,1] neg_hi:[0,1]
    v_pk_add_f32 v[22:23], v[22:23], s[26:27] op_sel_hi:[1,0] neg_lo:[0,1] neg_hi:[0,1]
    v_pk_mul_f32 v[68:69], v[16:17], v[16:17]
    v_pk_mul_f32 v[70:71], v[18:19], v[18:19]
    v_pk_fma_f32 v[68:69], v[20:21], v[20:21], v[68:69]
    v_pk_fma_f32 v[70:71], v[22:23], v[22:23], v[70:71]
    v_pk_add_f32 v[68:69], v[68:69], v[70:71]
    v_add_f32 v0, v68, v69
    v_pk_add_f32 v[24:25], v[24:25], s[28:29] op_sel_hi:[1,0] neg_lo:[0,1] neg_hi:[0,1]
    v_pk_add_f32 v[26:27], v[26:27], s[28:29] op_sel_hi:[1,0] neg_lo:[0,1] neg_hi:[0,1]
    v_pk_add_f32 v[28:29], v[28:29], s[28:29] op_sel_hi:[1,0] neg_lo:[0,1] neg_hi:[0,1]
    v_pk_add_f32 v[30:31], v[30:31], s[28:29] op_sel_hi:[1,0] neg_lo:[0,1] neg_hi:[0,1]
    v_pk_mul_f32 v[64:65], v[24:25], v[24:25]
    v_pk_mul_f32 v[66:67], v[26:27], v[26:27]
    v_pk_fma_f32 v[64:65], v[28:29], v[28:29], v[64:65]
    v_pk_fma_f32 v[66:67], v[30:31], v[30:31], v[66:67]
    v_pk_add_f32 v[64:65], v[64:65], v[66:67]
    v_add_f32 v5, v64, v65
    v_pk_add_f32 v[32:33], v[32:33], s[30:31] op_sel_hi:[1,0] neg_lo:[0,1] neg_hi:[0,1]
    v_pk_add_f32 v[34:35], v[34:35], s[30:31] op_sel_hi:[1,0] neg_lo:[0,1] neg_hi:[0,1]
    v_pk_add_f32 v[36:37], v[36:37], s[30:31] op_sel_hi:[1,0] neg_lo:[0,1] neg_hi:[0,1]
    v_pk_add_f32 v[38:39], v[38:39], s[30:31] op_sel_hi:[1,0] neg_lo:[0,1] neg_hi:[0,1]
    v_pk_mul_f32 v[68:69], v[32:33], v[32:33]
    v_pk_mul_f32 v[70:71], v[34:35], v[34:35]
    v_pk_fma_f32 v[68:69], v[36:37], v[36:37], v[68:69]
    v_pk_fma_f32 v[70:71], v[38:39], v[38:39], v[70:71]
    v_pk_add_f32 v[68:69], v[68:69], v[70:71]
    v_add_f32 v6, v68, v69
    v_pk_mul_f32 v[8:9], v[8:9], v[48:49]
    v_permlane32_swap_b32 v2, v0
    v_permlane32_swap_b32 v5, v6
    v_add_f32 v2, v2, v0
    v_add_f32 v5, v5, v6
    v_pk_mul_f32 v[10:11], v[10:11], v[50:51]
    v_pk_mul_f32 v[12:13], v[12:13], v[52:53]
    v_permlane16_swap_b32 v2, v5
    v_add_f32 v2, v2, v5
    v_pk_mul_f32 v[14:15], v[14:15], v[54:55]
    v_pk_mul_f32 v[16:17], v[16:17], v[48:49]
    v_add_f32_dpp v2, v2, v2 quad_perm:[1,0,3,2] row_mask:0xf bank_mask:0xf
    v_pk_mul_f32 v[18:19], v[18:19], v[50:51]
    v_pk_mul_f32 v[20:21], v[20:21], v[52:53]
    v_add_f32_dpp v2, v2, v2 quad_perm:[2,3,0,1] row_mask:0xf bank_mask:0xf
    v_pk_mul_f32 v[22:23], v[22:23], v[54:55]
    v_pk_mul_f32 v[24:25], v[24:25], v[48:49]
    v_add_f32_dpp v2, v2, v2 row_half_mirror row_mask:0xf bank_mask:0xf
    v_pk_mul_f32 v[26:27], v[26:27], v[50:51]
    v_pk_mul_f32 v[28:29], v[28:29], v[52:53]
    v_add_f32_dpp v2, v2, v2 row_mirror row_mask:0xf bank_mask:0xf
    v_pk_mul_f32 v[30:31], v[30:31], v[54:55]
    v_pk_mul_f32 v[32:33], v[32:33], v[48:49]
    v_pk_mul_f32 v[34:35], v[34:35], v[50:51]
    v_pk_mul_f32 v[36:37], v[36:37], v[52:53]
    v_pk_mul_f32 v[38:39], v[38:39], v[54:55]
    v_fma_f32 v2, v2, s22, v3
    v_rsq_f32 v2, v2
    s_nop 0
    v_readlane_b32 s32, v2, 0
    v_readlane_b32 s34, v2, 32
    v_readlane_b32 s36, v2, 16
    v_readlane_b32 s38, v2, 48
    v_pk_fma_f32 v[8:9], v[8:9], s[32:33], v[56:57] op_sel_hi:[1,0,1]
    v_pk_fma_f32 v[10:11], v[10:11], s[32:33], v[58:59] op_sel_hi:[1,0,1]
    v_pk_fma_f32 v[12:13], v[12:13], s[32:33], v[60:61] op_sel_hi:[1,0,1]
    v_pk_fma_f32 v[14:15], v[14:15], s[32:33], v[62:63] op_sel_hi:[1,0,1]
    v_cvt_pk_bf16_f32 v8, v8, v9
    v_cvt_pk_bf16_f32 v9, v10, v11
    v_cvt_pk_bf16_f32 v10, v12, v13
    v_cvt_pk_bf16_f32 v11, v14, v15
    v_pk_fma_f32 v[16:17], v[16:17], s[34:35], v[56:57] op_sel_hi:[1,0,1]
    v_pk_fma_f32 v[18:19], v[18:19], s[34:35], v[58:59] op_sel_hi:[1,0,1]
    v_pk_fma_f32 v[20:21], v[20:21], s[34:35], v[60:61] op_sel_hi:[1,0,1]
    v_pk_fma_f32 v[22:23], v[22:23], s[34:35], v[62:63] op_sel_hi:[1,0,1]
    v_cvt_pk_bf16_f32 v16, v16, v17
    v_cvt_pk_bf16_f32 v17, v18, v19
    v_cvt_pk_bf16_f32 v18, v20, v21
    v_cvt_pk_bf16_f32 v19, v22, v23
    v_pk_fma_f32 v[24:25], v[24:25], s[36:37], v[56:57] op_sel_hi:[1,0,1]
    v_pk_fma_f32 v[26:27], v[26:27], s[36:37], v[58:59] op_sel_hi:[1,0,1]
    v_pk_fma_f32 v[28:29], v[28:29], s[36:37], v[60:61] op_sel_hi:[1,0,1]
    v_pk_fma_f32 v[30:31], v[30:31], s[36:37], v[62:63] op_sel_hi:[1,0,1]
    v_cvt_pk_bf16_f32 v24, v24, v25
    v_cvt_pk_bf16_f32 v25, v26, v27
    v_cvt_pk_bf16_f32 v26, v28, v29
    v_cvt_pk_bf16_f32 v27, v30, v31
    v_pk_fma_f32 v[32:33], v[32:33], s[38:39], v[56:57] op_sel_hi:[1,0,1]
    v_pk_fma_f32 v[34:35], v[34:35], s[38:39], v[58:59] op_sel_hi:[1,0,1]
    v_pk_fma_f32 v[36:37], v[36:37], s[38:39], v[60:61] op_sel_hi:[1,0,1]
    v_pk_fma_f32 v[38:39], v[38:39], s[38:39], v[62:63] op_sel_hi:[1,0,1]
    v_cvt_pk_bf16_f32 v32, v32, v33
    v_cvt_pk_bf16_f32 v33, v34, v35
    v_cvt_pk_bf16_f32 v34, v36, v37
    v_cvt_pk_bf16_f32 v35, v38, v39
L_pl:
    ds_read_b32 v80, v7
    s_waitcnt lgkmcnt(0)
    v_readfirstlane_b32 s21, v80
    s_cmp_ge_u32 s21, 14
    s_cbranch_scc1 L_st
    s_branch L_pl
L_st:
    global_store_dwordx4 v1, v[8:11], s[14:15] offset:-4096 nt
    global_store_dwordx4 v4, v[16:19], s[14:15] offset:-4096 nt
    global_store_dwordx4 v1, v[24:27], s[14:15] offset:0 nt
    global_store_dwordx4 v4, v[32:35], s[14:15] offset:0 nt
L_end:
    s_endpgm
.section .rodata,"a"
.p2align 6
.amdhsa_kernel standalone__deepnorm__sampling_kernel
  .amdhsa_next_free_vgpr 81
  .amdhsa_next_free_sgpr 40
  .amdhsa_accum_offset 84
  .amdhsa_group_segment_fixed_size 0
  .amdhsa_kernarg_size 64
  .amdhsa_user_sgpr_count 2
  .amdhsa_user_sgpr_kernarg_segment_ptr 1
  .amdhsa_system_sgpr_workgroup_id_x 1
  .amdhsa_float_denorm_mode_32 3
.end_amdhsa_kernel
```
